```python
import torch

def _softmax(x, axis=-1):
    return torch.softmax(x, dim=axis)
def _gelu(x):
    return torch.nn.functional.gelu(x, approximate="tanh")
def _silu(x):
    return torch.nn.functional.silu(x)
def _sigmoid(x):
    return torch.sigmoid(x)
def _layernorm(x, axis=-1, eps=1e-5):
    m = x.mean(dim=axis, keepdim=True)
    v = x.var(dim=axis, keepdim=True, unbiased=False)
    return (x - m) / torch.sqrt(v + eps)
def _scatter_add(tgt, idx, src, axis=0):
    return tgt.clone().index_add_(axis, idx, src)
def _segment_sum(src, seg, n):
    out = torch.zeros((n,) + src.shape[1:], dtype=src.dtype)
    return out.index_add_(0, seg, src)
def _pad(x, pw):
    flat = tuple(v for pair in reversed(pw) for v in pair)
    return torch.nn.functional.pad(x, flat)

kernel_name = 'standalone__low_rank_proj_linformer__sampling'

def setup_inputs():

    _w = (lambda a: (lambda t: t.to(torch.bfloat16) if t.is_floating_point() else t)(torch.as_tensor(a)))
    B, H, Sq, Skv, Dh, R = 8, 32, 4, 2048, 128, 64
    return {
        "q": _w((lambda *s: torch.randn(*s, dtype=torch.bfloat16) * 0.8)(B, H, Sq, Dh)),
        "k": _w((lambda *s: torch.randn(*s, dtype=torch.bfloat16) * 0.8)(B, H, Skv, Dh)),
        "v": _w((lambda *s: torch.randn(*s, dtype=torch.bfloat16) * 0.05)(B, H, Skv, Dh)),
        "e_proj": _w((lambda *s: torch.randn(*s, dtype=torch.bfloat16) * 0.8)(R, Skv) * (Skv ** -0.5)),
        "f_proj": _w((lambda *s: torch.randn(*s, dtype=torch.bfloat16) * 0.05)(R, Skv) * (Skv ** -0.5)),
    }

def reference(q, k, v, e_proj, f_proj):
    B, H, Sq, Dh = q.shape
    kp = torch.einsum("rn,bhnd->bhrd", e_proj, k)
    vp = torch.einsum("rn,bhnd->bhrd", f_proj, v)
    scores = torch.einsum("bhqd,bhrd->bhqr", q, kp) * (Dh ** -0.5)
    p = _softmax(scores, axis=-1)
    o = torch.einsum("bhqr,bhrd->bhqd", p, vp)
    return o
```

```asm
; @launch grid=(256,1,1) block=(192,1,1) lds=136320
.amdgcn_target "amdgcn-amd-amdhsa--gfx950"
.text
.globl standalone__low_rank_proj_linformer__sampling_kernel

.p2align 8
.type standalone__low_rank_proj_linformer__sampling_kernel,@function
standalone__low_rank_proj_linformer__sampling_kernel:
    s_load_dwordx2 s[8:9], s[0:1], 8
    s_load_dwordx2 s[12:13], s[0:1], 24
    v_readfirstlane_b32 s32, v0
    s_cmpk_ge_u32 s2, 256
    s_cbranch_scc1 L_end
    s_brev_b32 s5, s2
    s_lshr_b32 s3, s2, 3
    s_lshr_b32 s4, s2, 4
    s_xor_b32 s3, s3, s2
    s_xor_b32 s4, s4, s2
    s_and_b32 s3, s3, 2
    s_and_b32 s4, s4, 4
    s_mul_i32 s3, s3, 9
    s_mul_i32 s4, s4, 17
    s_xor_b32 s2, s2, s3
    s_xor_b32 s2, s2, s4
    s_cmp_lg_u32 s32, 0
    s_cbranch_scc1 L_consumer
    v_lshrrev_b32 v3, 4, v0
    v_xor_b32 v4, v0, v3
    s_lshl_b32 s28, s2, 19
    v_lshl_add_u32 v8, v4, 4, s28
    v_xor_b32 v9, 64, v8
    s_lshr_b32 s42, s5, 27
    s_and_b32 s42, s42, 26
    s_lshl_b32 s34, s42, 14
    s_lshl_b32 s10, 1, 27
    s_mov_b32 s11, 0x20000
    s_mov_b32 m0, 0
    s_waitcnt lgkmcnt(0)
    s_waitcnt vmcnt(30)
    buffer_load_dwordx4 v8, s[8:11], s34 offen offset:0 nt lds
    buffer_load_dwordx4 v8, s[8:11], s34 offen offset:1024 nt lds
    s_waitcnt vmcnt(30)
    buffer_load_dwordx4 v9, s[8:11], s34 offen offset:2048 nt lds
    buffer_load_dwordx4 v9, s[8:11], s34 offen offset:3072 nt lds
    v_lshrrev_b32 v4, 5, v0
    v_and_b32 v6, 1, v3
    v_lshl_or_b32 v4, v4, 2, v6
    v_and_b32 v6, 7, v0
    v_xor_b32 v4, v4, v6
    v_lshrrev_b32 v6, 3, v0
    v_lshlrev_b32 v6, 12, v6
    v_lshl_add_u32 v12, v4, 4, v6
    s_movk_i32 s43, 31744
    v_xad_u32 v13, v12, 32, s43
    s_load_dwordx2 s[24:25], s[0:1], 16
    s_load_dwordx2 s[26:27], s[0:1], 32
    s_lshl_b32 s35, s42, 7
    s_lshl_b32 s14, 1, 18
    s_mov_b32 s15, s11
    s_lshl_b32 s33, 1, 16
    s_mov_b32 s38, 0
    s_movk_i32 s37, 0x1000
    s_mov_b32 s36, 0
    s_mov_b32 s60, 0x80000010
    s_mov_b32 s61, 0x80000001
    v_xor_b32 v10, 0x80, v8
    v_xor_b32 v11, 64, v10
    s_branch L_lmid
L_hwait:
    s_cmpk_lt_u32 s36, 2
    s_cbranch_scc1 L_lloop
    s_waitcnt vmcnt(36)
    s_barrier
L_lwait:
L_lloop:
    s_waitcnt vmcnt(50)
    s_mov_b32 m0, s37
    s_addk_i32 s37, 0x1000
    s_waitcnt vmcnt(30)
    buffer_load_dwordx4 v8, s[8:11], s34 offen offset:0 nt lds
    buffer_load_dwordx4 v8, s[8:11], s34 offen offset:1024 nt lds
    s_waitcnt vmcnt(30)
    buffer_load_dwordx4 v9, s[8:11], s34 offen offset:2048 nt lds
    buffer_load_dwordx4 v9, s[8:11], s34 offen offset:3072 nt lds
L_lmid:
    s_addk_i32 s34, 0x1000
    s_add_u32 m0, s38, s33
    s_addk_i32 s38, 0x800
    s_waitcnt vmcnt(30)
    buffer_load_dwordx4 v12, s[12:15], s35 offen  lds
    buffer_load_dwordx4 v13, s[12:15], s35 offen offset:1024  lds
    s_add_u32 s35, s35, s33
    s_mov_b32 m0, s37
    s_addk_i32 s37, 0x1000
    s_waitcnt vmcnt(30)
    buffer_load_dwordx4 v10, s[8:11], s34 offen offset:0 nt lds
    buffer_load_dwordx4 v10, s[8:11], s34 offen offset:1024 nt lds
    s_waitcnt vmcnt(30)
    buffer_load_dwordx4 v11, s[8:11], s34 offen offset:2048 nt lds
    buffer_load_dwordx4 v11, s[8:11], s34 offen offset:3072 nt lds
    s_addk_i32 s34, 0x1000
    s_add_u32 m0, s38, s33
    s_addk_i32 s38, 0x800
    s_waitcnt vmcnt(30)
    buffer_load_dwordx4 v12, s[12:15], s35 offen  lds
    buffer_load_dwordx4 v13, s[12:15], s35 offen offset:1024  lds
    s_add_u32 s35, s35, s33
    s_bitcmp1_b32 s37, 13
    s_cbranch_scc1 L_hwait
    s_bitset0_b32 s35, 18
    s_addk_i32 s35, 128
    s_bitset0_b32 s35, 12
    s_bitset0_b32 s38, 16
    s_bitset0_b32 s34, 19
    s_bitset0_b32 s37, 16
    s_addk_i32 s36, 1
    s_bitcmp0_b64 s[60:61], s36
    s_cbranch_scc1 L_lloop
    s_cmpk_eq_u32 s36, 63
    s_cbranch_scc1 L_ltail
    s_cmpk_lg_u32 s36, 4
    s_cbranch_scc1 L_r2
    s_waitcnt vmcnt(54)
    s_add_u32 m0, s38, s33
    s_addk_i32 s38, 0x800
    s_waitcnt vmcnt(30)
    buffer_load_dwordx4 v12, s[12:15], s35 offen  lds
    buffer_load_dwordx4 v13, s[12:15], s35 offen offset:1024  lds
    s_add_u32 s35, s35, s33
    s_add_u32 m0, s38, s33
    s_addk_i32 s38, 0x800
    s_waitcnt vmcnt(30)
    buffer_load_dwordx4 v12, s[12:15], s35 offen  lds
    buffer_load_dwordx4 v13, s[12:15], s35 offen offset:1024  lds
    s_add_u32 s35, s35, s33
    s_add_u32 m0, s38, s33
    s_addk_i32 s38, 0x800
    s_waitcnt vmcnt(30)
    buffer_load_dwordx4 v12, s[12:15], s35 offen  lds
    buffer_load_dwordx4 v13, s[12:15], s35 offen offset:1024  lds
    s_add_u32 s35, s35, s33
    s_add_u32 m0, s38, s33
    s_addk_i32 s38, 0x800
    s_waitcnt vmcnt(30)
    buffer_load_dwordx4 v12, s[12:15], s35 offen  lds
    buffer_load_dwordx4 v13, s[12:15], s35 offen offset:1024  lds
    s_add_u32 s35, s35, s33
    s_bitset0_b32 s35, 18
    s_addk_i32 s35, 128
    s_bitset0_b32 s35, 12
    s_bitset0_b32 s38, 16
    s_branch L_lwait
L_r2:
    s_cmpk_lg_u32 s36, 31
    s_cbranch_scc1 L_r3
    s_waitcnt lgkmcnt(0)
    s_mov_b64 s[12:13], s[26:27]
    s_branch L_lwait
L_r3:
    s_waitcnt lgkmcnt(0)
    s_mov_b64 s[8:9], s[24:25]
    v_lshlrev_b32 v4, 1, v3
    v_xor_b32 v4, v0, v4
    v_lshl_add_u32 v8, v4, 4, s28
    v_xor_b32 v9, 0x80, v8
    v_mov_b32 v10, v8
    v_mov_b32 v11, v9
    s_waitcnt lgkmcnt(0)
    s_branch L_lwait
L_ltail:
    s_waitcnt vmcnt(50)
    s_mov_b32 m0, s37
    s_addk_i32 s37, 0x1000
    s_waitcnt vmcnt(30)
    buffer_load_dwordx4 v8, s[8:11], s34 offen offset:0 nt lds
    buffer_load_dwordx4 v8, s[8:11], s34 offen offset:1024 nt lds
    s_waitcnt vmcnt(30)
    buffer_load_dwordx4 v9, s[8:11], s34 offen offset:2048 nt lds
    buffer_load_dwordx4 v9, s[8:11], s34 offen offset:3072 nt lds
    s_addk_i32 s34, 0x1000
    s_mov_b32 m0, s37
    s_addk_i32 s37, 0x1000
    s_waitcnt vmcnt(30)
    buffer_load_dwordx4 v10, s[8:11], s34 offen offset:0 nt lds
    buffer_load_dwordx4 v10, s[8:11], s34 offen offset:1024 nt lds
    s_waitcnt vmcnt(30)
    buffer_load_dwordx4 v11, s[8:11], s34 offen offset:2048 nt lds
    buffer_load_dwordx4 v11, s[8:11], s34 offen offset:3072 nt lds
    s_addk_i32 s34, 0x1000
    s_waitcnt vmcnt(32)
    s_barrier
    s_mov_b32 m0, s37
    s_addk_i32 s37, 0x1000
    s_waitcnt vmcnt(30)
    buffer_load_dwordx4 v8, s[8:11], s34 offen offset:0 nt lds
    buffer_load_dwordx4 v8, s[8:11], s34 offen offset:1024 nt lds
    s_waitcnt vmcnt(30)
    buffer_load_dwordx4 v9, s[8:11], s34 offen offset:2048 nt lds
    buffer_load_dwordx4 v9, s[8:11], s34 offen offset:3072 nt lds
    s_addk_i32 s34, 0x1000
    s_mov_b32 m0, s37
    s_addk_i32 s37, 0x1000
    s_waitcnt vmcnt(30)
    buffer_load_dwordx4 v10, s[8:11], s34 offen offset:0 nt lds
    buffer_load_dwordx4 v10, s[8:11], s34 offen offset:1024 nt lds
    s_waitcnt vmcnt(30)
    buffer_load_dwordx4 v11, s[8:11], s34 offen offset:2048 nt lds
    buffer_load_dwordx4 v11, s[8:11], s34 offen offset:3072 nt lds
    s_addk_i32 s34, 0x1000
    s_waitcnt vmcnt(16)
    s_barrier
    s_waitcnt vmcnt(0)
    s_barrier
    s_endpgm
L_consumer:
    s_load_dwordx2 s[44:45], s[0:1], 0
    s_load_dwordx2 s[46:47], s[0:1], 40
    v_and_b32 v1, 63, v0
    v_lshlrev_b32 v5, 4, v1
    v_and_b32 v2, 15, v0
    v_lshrrev_b32 v3, 4, v1
    s_lshr_b32 s32, s32, 6
    s_sub_u32 s51, s32, 1
    s_lshl_b32 s42, s2, 10
    v_and_b32 v4, 3, v1
    v_lshlrev_b32 v4, 8, v4
    v_lshl_add_u32 v4, v3, 4, v4
    s_mov_b32 s18, 1024
    s_mov_b32 s19, 0x20000
    s_mov_b32 s22, 1024
    s_mov_b32 s23, 0x20000
    s_waitcnt lgkmcnt(0)
    s_add_u32 s16, s44, s42
    s_addc_u32 s17, s45, 0
    s_add_u32 s20, s46, s42
    s_addc_u32 s21, s47, 0
    s_lshl_b32 s43, s51, 10
    s_add_u32 s43, s43, 133248
    s_mov_b32 m0, s43
    v_add_u32 v7, s43, v4
    buffer_load_dwordx4 v5, s[16:19], 0 offen lds
    s_lshl_b32 s42, s51, 13
    s_lshl_b32 s43, s51, 2
    v_lshrrev_b32 v4, 2, v2
    v_and_b32 v6, 3, v2
    v_lshl_add_u32 v6, v4, 3, v6
    v_lshlrev_b32 v6, 8, v6
    v_xor_b32 v5, v2, v3
    v_lshl_add_u32 v6, v5, 4, v6
    v_add_u32 v6, s42, v6
    v_xor_b32 v8, 0, v6
    v_xor_b32 v9, 64, v6
    v_xor_b32 v10, 128, v6
    v_xor_b32 v11, 192, v6
    v_bfe_u32 v5, v2, 1, 1
    v_bfe_u32 v6, v2, 2, 1
    v_lshl_or_b32 v5, v6, 2, v5
    v_bfe_u32 v6, v2, 3, 1
    v_lshl_or_b32 v5, v6, 1, v5
    v_xor_b32 v5, v5, v3
    v_xor_b32 v5, s43, v5
    v_lshlrev_b32 v6, 7, v2
    v_lshl_add_u32 v12, v5, 4, v6
    v_add_u32 v12, 65536, v12
    v_lshrrev_b32 v5, 1, v4
    v_and_b32 v6, 1, v3
    v_lshl_or_b32 v5, v6, 2, v5
    v_and_b32 v6, 2, v3
    v_or_b32 v5, v5, v6
    v_and_b32 v6, 3, v2
    v_xor_b32 v5, v5, v6
    v_lshl_add_u32 v6, v3, 2, v4
    v_lshlrev_b32 v6, 7, v6
    v_lshl_add_u32 v13, v5, 4, v6
    v_add_u32 v13, 65536, v13
    v_xor_b32 v21, 64, v13
    v_lshl_add_u32 v5, v3, 3, v4
    v_lshlrev_b32 v5, 8, v5
    v_and_b32 v6, 1, v2
    v_lshl_add_u32 v5, v6, 3, v5
    v_bfe_u32 v6, v2, 1, 1
    v_lshl_or_b32 v6, v4, 1, v6
    v_and_b32 v16, 1, v3
    v_lshl_or_b32 v6, v16, 3, v6
    v_lshl_add_u32 v5, v6, 4, v5
    s_lshl_b32 s43, s51, 7
    v_xor_b32 v5, s43, v5
    v_xor_b32 v16, 0, v5
    v_xor_b32 v17, 32, v5
    v_xor_b32 v18, 64, v5
    v_xor_b32 v19, 96, v5
    v_and_b32 v5, 3, v2
    v_lshlrev_b32 v20, 8, v5
    v_lshl_add_u32 v20, v4, 5, v20
    v_lshl_add_u32 v20, v3, 3, v20
    v_add_u32 v20, s43, v20
    v_lshl_add_u32 v5, v5, 2, v3
    v_lshlrev_b32 v5, 6, v5
    s_lshl_b32 s42, s51, 10
    s_add_u32 s43, s42, 131072
    v_add_u32 v14, s43, v5
    s_xor_b32 s43, s43, 1024
    v_add_u32 v15, s43, v5
    s_mov_b32 s52, 0xf000f0
    s_mov_b32 s53, 0xf000f0
    s_mov_b32 s54, 0xf000f00
    s_mov_b32 s55, 0xf000f00
    s_mov_b32 s56, 0xf000f000
    s_mov_b32 s57, 0xf000f000
    v_mov_b32 v128, 0
    v_mov_b32 v129, 0
    v_mov_b32 v130, 0
    v_mov_b32 v131, 0
    v_mov_b32 v132, 0
    v_mov_b32 v133, 0
    v_mov_b32 v134, 0
    v_mov_b32 v135, 0
    v_mov_b32 v136, 0
    v_mov_b32 v137, 0
    v_mov_b32 v138, 0
    v_mov_b32 v139, 0
    v_mov_b32 v140, 0
    v_mov_b32 v141, 0
    v_mov_b32 v142, 0
    v_mov_b32 v143, 0
    s_lshl_b32 s42, s51, 6
    s_add_u32 s42, s42, 133120
    v_mov_b32 v22, s42
    v_xor_b32 v23, 64, v22
    ds_write_b32 v22, v128
    s_mov_b32 s36, 0
    s_waitcnt vmcnt(0)
    ds_read_b128 v[24:27], v7 offset:0
    ds_read_b128 v[28:31], v7 offset:64
    ds_read_b128 v[32:35], v7 offset:128
    ds_read_b128 v[36:39], v7 offset:192
    s_waitcnt lgkmcnt(0)
L_kloop:
    s_barrier
    ds_read_b128 v[40:43], v8 offset:0
    ds_read_b128 v[56:59], v8 offset:1024
    ds_read_b128 v[44:47], v9 offset:0
    ds_read_b128 v[60:63], v9 offset:1024
    ds_read_b128 v[48:51], v10 offset:0
    ds_read_b128 v[64:67], v10 offset:1024
    ds_read_b128 v[52:55], v11 offset:0
    ds_read_b128 v[68:71], v11 offset:1024
    ds_read_b128 v[72:75], v12 offset:0
    ds_read_b128 v[76:79], v12 offset:2048
    ds_read_b128 v[80:83], v12 offset:4096
    ds_read_b128 v[84:87], v12 offset:6144
    s_add_u32 s42, s36, 1
    s_xor_b32 s43, s42, s36
    s_and_b32 s49, s43, 3
    s_lshl_b32 s49, s49, 14
    s_and_b32 s50, s43, 7
    s_lshl_b32 s50, s50, 13
    s_mov_b32 s36, s42
    s_waitcnt lgkmcnt(10)
    v_mfma_f32_16x16x32_bf16 v[104:107], v[40:43], v[24:27], 0
    v_mfma_f32_16x16x32_bf16 v[108:111], v[56:59], v[24:27], 0
    s_waitcnt lgkmcnt(8)
    v_mfma_f32_16x16x32_bf16 v[104:107], v[44:47], v[28:31], v[104:107]
    v_mfma_f32_16x16x32_bf16 v[108:111], v[60:63], v[28:31], v[108:111]
    s_waitcnt lgkmcnt(6)
    v_mfma_f32_16x16x32_bf16 v[104:107], v[48:51], v[32:35], v[104:107]
    v_mfma_f32_16x16x32_bf16 v[108:111], v[64:67], v[32:35], v[108:111]
    s_waitcnt lgkmcnt(4)
    v_mfma_f32_16x16x32_bf16 v[104:107], v[52:55], v[36:39], v[104:107]
    v_mfma_f32_16x16x32_bf16 v[108:111], v[68:71], v[36:39], v[108:111]
    v_xor_b32 v8, s49, v8
    v_xor_b32 v9, s49, v9
    v_xor_b32 v10, s49, v10
    v_xor_b32 v11, s49, v11
    v_xor_b32 v12, s50, v12
    s_nop 2
    v_cvt_pk_bf16_f32 v120, v104, v105
    v_cvt_pk_bf16_f32 v121, v106, v107
    v_cvt_pk_bf16_f32 v122, v108, v109
    v_cvt_pk_bf16_f32 v123, v110, v111
    s_waitcnt lgkmcnt(0)
    s_cmp_lt_u32 s36, 32
    v_mfma_f32_16x16x32_bf16 v[128:131], v[72:75], v[120:123], v[128:131]
    v_mfma_f32_16x16x32_bf16 v[132:135], v[76:79], v[120:123], v[132:135]
    v_mfma_f32_16x16x32_bf16 v[136:139], v[80:83], v[120:123], v[136:139]
    v_mfma_f32_16x16x32_bf16 v[140:143], v[84:87], v[120:123], v[140:143]
    s_cbranch_scc1 L_kloop
    s_mov_b32 exec_lo, 0x000f000f
    s_mov_b32 exec_hi, 0x000f000f
    s_nop 5
    ds_write_b128 v14, v[128:131] offset:0
    ds_write_b128 v14, v[132:135] offset:16
    ds_write_b128 v14, v[136:139] offset:32
    ds_write_b128 v14, v[140:143] offset:48
    s_mov_b64 exec, -1
    v_mov_b32 v4, 1
    s_waitcnt lgkmcnt(0)
    ds_write_b32 v22, v4
L_poll:
    ds_read_b32 v5, v23
    ds_read_b128 v[40:43], v15 offset:0
    ds_read_b128 v[44:47], v15 offset:16
    ds_read_b128 v[48:51], v15 offset:32
    ds_read_b128 v[52:55], v15 offset:48
    s_waitcnt lgkmcnt(0)
    v_readfirstlane_b32 s42, v5
    s_nop 0
    s_cmp_eq_u32 s42, 0
    s_cbranch_scc1 L_poll
    v_add_f32 v128, v128, v40
    v_add_f32 v129, v129, v41
    v_add_f32 v130, v130, v42
    v_add_f32 v131, v131, v43
    v_add_f32 v132, v132, v44
    v_add_f32 v133, v133, v45
    v_add_f32 v134, v134, v46
    v_add_f32 v135, v135, v47
    v_add_f32 v136, v136, v48
    v_add_f32 v137, v137, v49
    v_add_f32 v138, v138, v50
    v_add_f32 v139, v139, v51
    v_add_f32 v140, v140, v52
    v_add_f32 v141, v141, v53
    v_add_f32 v142, v142, v54
    v_add_f32 v143, v143, v55
    v_max3_f32 v4, v128, v129, v130
    v_max3_f32 v4, v4, v131, v132
    v_max3_f32 v4, v4, v133, v134
    v_max3_f32 v4, v4, v135, v136
    v_max3_f32 v4, v4, v137, v138
    v_max3_f32 v4, v4, v139, v140
    v_max3_f32 v4, v4, v141, v142
    v_max_f32 v4, v4, v143
    v_mov_b32 v5, v4
    s_nop 1
    v_permlane32_swap_b32 v4, v5
    s_nop 1
    v_max_f32 v4, v4, v5
    v_mov_b32 v5, v4
    s_nop 1
    v_permlane16_swap_b32 v4, v5
    s_nop 1
    v_max_f32 v4, v4, v5
    s_mov_b32 s48, 0x3e0293ee
    v_mul_f32 v4, s48, v4
    v_fma_f32 v128, v128, s48, -v4
    v_fma_f32 v129, v129, s48, -v4
    v_fma_f32 v130, v130, s48, -v4
    v_fma_f32 v131, v131, s48, -v4
    v_fma_f32 v132, v132, s48, -v4
    v_fma_f32 v133, v133, s48, -v4
    v_fma_f32 v134, v134, s48, -v4
    v_fma_f32 v135, v135, s48, -v4
    v_fma_f32 v136, v136, s48, -v4
    v_fma_f32 v137, v137, s48, -v4
    v_fma_f32 v138, v138, s48, -v4
    v_fma_f32 v139, v139, s48, -v4
    v_fma_f32 v140, v140, s48, -v4
    v_fma_f32 v141, v141, s48, -v4
    v_fma_f32 v142, v142, s48, -v4
    v_fma_f32 v143, v143, s48, -v4
    v_exp_f32 v128, v128
    v_exp_f32 v129, v129
    v_exp_f32 v130, v130
    v_exp_f32 v131, v131
    v_exp_f32 v132, v132
    v_exp_f32 v133, v133
    v_exp_f32 v134, v134
    v_exp_f32 v135, v135
    v_exp_f32 v136, v136
    v_exp_f32 v137, v137
    v_exp_f32 v138, v138
    v_exp_f32 v139, v139
    v_exp_f32 v140, v140
    v_exp_f32 v141, v141
    v_exp_f32 v142, v142
    v_exp_f32 v143, v143
    s_nop 0
    v_add_f32 v4, v128, v129
    v_add_f32 v4, v4, v130
    v_add_f32 v4, v4, v131
    v_add_f32 v4, v4, v132
    v_add_f32 v4, v4, v133
    v_add_f32 v4, v4, v134
    v_add_f32 v4, v4, v135
    v_add_f32 v4, v4, v136
    v_add_f32 v4, v4, v137
    v_add_f32 v4, v4, v138
    v_add_f32 v4, v4, v139
    v_add_f32 v4, v4, v140
    v_add_f32 v4, v4, v141
    v_add_f32 v4, v4, v142
    v_add_f32 v4, v4, v143
    v_mov_b32 v5, v4
    s_nop 1
    v_permlane32_swap_b32 v4, v5
    s_nop 1
    v_add_f32 v4, v4, v5
    v_mov_b32 v5, v4
    s_nop 1
    v_permlane16_swap_b32 v4, v5
    s_nop 1
    v_add_f32 v4, v4, v5
    v_rcp_f32 v4, v4
    s_nop 0
    v_mul_f32 v128, v128, v4
    v_mul_f32 v129, v129, v4
    v_mul_f32 v130, v130, v4
    v_mul_f32 v131, v131, v4
    v_mul_f32 v132, v132, v4
    v_mul_f32 v133, v133, v4
    v_mul_f32 v134, v134, v4
    v_mul_f32 v135, v135, v4
    v_mul_f32 v136, v136, v4
    v_mul_f32 v137, v137, v4
    v_mul_f32 v138, v138, v4
    v_mul_f32 v139, v139, v4
    v_mul_f32 v140, v140, v4
    v_mul_f32 v141, v141, v4
    v_mul_f32 v142, v142, v4
    v_mul_f32 v143, v143, v4
    v_cvt_pk_bf16_f32 v24, v128, v129
    v_cvt_pk_bf16_f32 v25, v130, v131
    v_cvt_pk_bf16_f32 v26, v132, v133
    v_cvt_pk_bf16_f32 v27, v134, v135
    v_cvt_pk_bf16_f32 v28, v136, v137
    v_cvt_pk_bf16_f32 v29, v138, v139
    v_cvt_pk_bf16_f32 v30, v140, v141
    v_cvt_pk_bf16_f32 v31, v142, v143
    v_mov_b32 v128, 0
    v_mov_b32 v129, 0
    v_mov_b32 v130, 0
    v_mov_b32 v131, 0
    v_mov_b32 v132, 0
    v_mov_b32 v133, 0
    v_mov_b32 v134, 0
    v_mov_b32 v135, 0
    v_mov_b32 v136, 0
    v_mov_b32 v137, 0
    v_mov_b32 v138, 0
    v_mov_b32 v139, 0
    v_mov_b32 v140, 0
    v_mov_b32 v141, 0
    v_mov_b32 v142, 0
    v_mov_b32 v143, 0
L_vloop:
    ds_read_b64_tr_b16 v[72:73], v13 offset:0
    ds_read_b64_tr_b16 v[74:75], v13 offset:2048
    ds_read_b64_tr_b16 v[80:81], v13 offset:8
    ds_read_b64_tr_b16 v[82:83], v13 offset:2056
    ds_read_b64_tr_b16 v[88:89], v21 offset:0
    ds_read_b64_tr_b16 v[90:91], v21 offset:2048
    ds_read_b64_tr_b16 v[96:97], v21 offset:8
    ds_read_b64_tr_b16 v[98:99], v21 offset:2056
    ds_read_b64_tr_b16 v[76:77], v13 offset:4096
    ds_read_b64_tr_b16 v[78:79], v13 offset:6144
    ds_read_b64_tr_b16 v[84:85], v13 offset:4104
    ds_read_b64_tr_b16 v[86:87], v13 offset:6152
    ds_read_b64_tr_b16 v[92:93], v21 offset:4096
    ds_read_b64_tr_b16 v[94:95], v21 offset:6144
    s_waitcnt lgkmcnt(13)
    ds_read_b64_tr_b16 v[100:101], v21 offset:4104
    ds_read_b64_tr_b16 v[102:103], v21 offset:6152
    s_waitcnt lgkmcnt(8)
    v_mfma_f32_16x16x32_bf16 v[104:107], v[72:75], v[24:27], 0
    v_mfma_f32_16x16x32_bf16 v[108:111], v[80:83], v[24:27], 0
    v_mfma_f32_16x16x32_bf16 v[112:115], v[88:91], v[24:27], 0
    v_mfma_f32_16x16x32_bf16 v[116:119], v[96:99], v[24:27], 0
    s_waitcnt lgkmcnt(0)
    v_mfma_f32_16x16x32_bf16 v[104:107], v[76:79], v[28:31], v[104:107]
    v_mfma_f32_16x16x32_bf16 v[108:111], v[84:87], v[28:31], v[108:111]
    v_mfma_f32_16x16x32_bf16 v[112:115], v[92:95], v[28:31], v[112:115]
    v_mfma_f32_16x16x32_bf16 v[116:119], v[100:103], v[28:31], v[116:119]
    s_nop 4
    v_cvt_pk_bf16_f32 v120, v104, v105
    v_cvt_pk_bf16_f32 v121, v106, v107
    v_cvt_pk_bf16_f32 v122, v108, v109
    v_cvt_pk_bf16_f32 v123, v110, v111
    v_cvt_pk_bf16_f32 v124, v112, v113
    v_cvt_pk_bf16_f32 v125, v114, v115
    v_cvt_pk_bf16_f32 v126, v116, v117
    v_cvt_pk_bf16_f32 v127, v118, v119
    s_barrier
L_vbody:
    ds_read_b64_tr_b16 v[40:41], v16 offset:0
    ds_read_b64_tr_b16 v[42:43], v16 offset:1024
    ds_read_b64_tr_b16 v[44:45], v17 offset:0
    ds_read_b64_tr_b16 v[46:47], v17 offset:1024
    ds_read_b64_tr_b16 v[48:49], v18 offset:0
    ds_read_b64_tr_b16 v[50:51], v18 offset:1024
    ds_read_b64_tr_b16 v[52:53], v19 offset:0
    ds_read_b64_tr_b16 v[54:55], v19 offset:1024
    ds_read_b64_tr_b16 v[56:57], v16 offset:8192
    ds_read_b64_tr_b16 v[58:59], v16 offset:9216
    ds_read_b64_tr_b16 v[60:61], v17 offset:8192
    ds_read_b64_tr_b16 v[62:63], v17 offset:9216
    ds_read_b64_tr_b16 v[64:65], v18 offset:8192
    ds_read_b64_tr_b16 v[66:67], v18 offset:9216
    s_waitcnt lgkmcnt(13)
    ds_read_b64_tr_b16 v[68:69], v19 offset:8192
    ds_read_b64_tr_b16 v[70:71], v19 offset:9216
    s_add_u32 s42, s36, 1
    s_xor_b32 s43, s42, s36
    s_and_b32 s49, s43, 3
    s_lshl_b32 s49, s49, 14
    s_and_b32 s50, s43, 7
    s_lshl_b32 s50, s50, 13
    s_mov_b32 s36, s42
    s_cmp_lt_u32 s36, 64
    s_waitcnt lgkmcnt(14)
    v_mfma_f32_16x16x32_bf16 v[128:131], v[40:43], v[120:123], v[128:131]
    s_waitcnt lgkmcnt(12)
    v_mfma_f32_16x16x32_bf16 v[132:135], v[44:47], v[120:123], v[132:135]
    s_waitcnt lgkmcnt(10)
    v_mfma_f32_16x16x32_bf16 v[136:139], v[48:51], v[120:123], v[136:139]
    s_waitcnt lgkmcnt(8)
    v_mfma_f32_16x16x32_bf16 v[140:143], v[52:55], v[120:123], v[140:143]
    s_waitcnt lgkmcnt(6)
    v_mfma_f32_16x16x32_bf16 v[128:131], v[56:59], v[124:127], v[128:131]
    v_xor_b32 v16, s49, v16
    v_xor_b32 v17, s49, v17
    s_waitcnt lgkmcnt(4)
    v_mfma_f32_16x16x32_bf16 v[132:135], v[60:63], v[124:127], v[132:135]
    v_xor_b32 v18, s49, v18
    v_xor_b32 v19, s49, v19
    s_waitcnt lgkmcnt(2)
    v_mfma_f32_16x16x32_bf16 v[136:139], v[64:67], v[124:127], v[136:139]
    v_xor_b32 v13, s50, v13
    v_xor_b32 v21, s50, v21
    s_waitcnt lgkmcnt(0)
    v_mfma_f32_16x16x32_bf16 v[140:143], v[68:71], v[124:127], v[140:143]
    v_cvt_pk_bf16_f32 v32, v128, v129
    v_cvt_pk_bf16_f32 v33, v130, v131
    v_cvt_pk_bf16_f32 v34, v132, v133
    v_cvt_pk_bf16_f32 v35, v134, v135
    v_cndmask_b32 v32, v32, v34, s[52:53]
    v_cndmask_b32 v33, v33, v35, s[52:53]
    v_cvt_pk_bf16_f32 v36, v136, v137
    v_cvt_pk_bf16_f32 v37, v138, v139
    v_cvt_pk_bf16_f32 v38, v140, v141
    v_cvt_pk_bf16_f32 v39, v142, v143
    v_cndmask_b32 v32, v32, v36, s[54:55]
    v_cndmask_b32 v33, v33, v37, s[54:55]
    v_cndmask_b32 v32, v32, v38, s[56:57]
    v_cndmask_b32 v33, v33, v39, s[56:57]
    s_cbranch_scc1 L_vloop
    buffer_store_dwordx2 v[32:33], v20, s[20:23], 0 offen
L_fin:
L_end:
    s_endpgm
.section .rodata,"a"
.p2align 6
.amdhsa_kernel standalone__low_rank_proj_linformer__sampling_kernel
  .amdhsa_next_free_vgpr 144
  .amdhsa_next_free_sgpr 64
  .amdhsa_accum_offset 144
  .amdhsa_group_segment_fixed_size 0
  .amdhsa_kernarg_size 64
  .amdhsa_user_sgpr_count 2
  .amdhsa_user_sgpr_kernarg_segment_ptr 1
  .amdhsa_system_sgpr_workgroup_id_x 1
.end_amdhsa_kernel
```
